```python
import torch

def _softmax(x, axis=-1):
    return torch.softmax(x, dim=axis)
def _gelu(x):
    return torch.nn.functional.gelu(x, approximate="tanh")
def _silu(x):
    return torch.nn.functional.silu(x)
def _sigmoid(x):
    return torch.sigmoid(x)
def _layernorm(x, axis=-1, eps=1e-5):
    m = x.mean(dim=axis, keepdim=True)
    v = x.var(dim=axis, keepdim=True, unbiased=False)
    return (x - m) / torch.sqrt(v + eps)
def _scatter_add(tgt, idx, src, axis=0):
    return tgt.clone().index_add_(axis, idx, src)
def _segment_sum(src, seg, n):
    out = torch.zeros((n,) + src.shape[1:], dtype=src.dtype)
    return out.index_add_(0, seg, src)
def _pad(x, pw):
    flat = tuple(v for pair in reversed(pw) for v in pair)
    return torch.nn.functional.pad(x, flat)

kernel_name = 'standalone__grn__sampling'

def setup_inputs():

    _w = (lambda a: (lambda t: t.to(torch.bfloat16) if t.is_floating_point() else t)(torch.as_tensor(a)))
    B, S, D = 1024, 32, 448
    return {
        "x": _w((lambda *s: torch.randn(*s, dtype=torch.bfloat16) * 0.05)(B, S, D)),
        "g": _w((lambda *s: torch.randn(*s, dtype=torch.bfloat16) * 0.4)(D) * 0.1),
        "b": _w((lambda *s: torch.randn(*s, dtype=torch.bfloat16) * 0.1)(D) * 0.1),
    }

def reference(x, g, b):
    gx = torch.sqrt((x * x).sum(axis=-2, keepdims=True))
    nx = gx / (gx.mean(axis=-1, keepdims=True) + 1e-6)
    return g * (x * nx) + b + x
```

```asm
; @launch grid=(512,1,1) block=(256,1,1) lds=7168
.amdgcn_target "amdgcn-amd-amdhsa--gfx950"
.text
.globl standalone__grn__sampling_kernel
.p2align 8
.type standalone__grn__sampling_kernel,@function
standalone__grn__sampling_kernel:
    s_load_dwordx4 s[4:7], s[0:1], 0
    s_load_dwordx4 s[8:11], s[0:1], 16
    s_cmp_ge_u32 s2, 512
    s_cbranch_scc1 L_done
    s_setprio 3
    v_lshrrev_b32 v2, 6, v0
    v_and_b32 v0, 63, v0
    v_lshlrev_b32 v3, 4, v0
    v_mul_u32_u24 v1, 14336, v2
    v_add_u32 v1, v1, v3
    v_xor_b32 v4, 1, v2
    v_mul_u32_u24 v4, 1792, v4
    v_add_u32 v4, v4, v3
    v_mul_u32_u24 v2, 1792, v2
    v_add_u32 v2, v2, v3
    v_mov_b32 v5, 0
    s_mul_i32 s3, s2, 57344
    s_mov_b32 s29, 4480
    s_mov_b32 s30, 8960
    s_mov_b32 s31, 13440
    s_mov_b32 s36, 0xffff0000
    s_mov_b32 s14, 57344
    s_mov_b32 s15, 0x00020000
    s_mov_b32 s18, 57344
    s_mov_b32 s19, 0x00020000
    s_mov_b32 s22, 896
    s_mov_b32 s23, 0x00020000
    s_mov_b32 s26, 896
    s_mov_b32 s27, 0x00020000
    s_mov_b32 exec_hi, 0x00ffffff
    s_waitcnt lgkmcnt(0)
    s_add_u32 s12, s4, s3
    s_addc_u32 s13, s5, 0
    buffer_load_dwordx4 v[60:63], v1, s[12:15], 0 offen offset:0 nt
    buffer_load_dwordx4 v[68:71], v1, s[12:15], 0 offen offset:896 nt
    buffer_load_dwordx4 v[76:79], v1, s[12:15], 0 offen offset:1792 nt
    buffer_load_dwordx4 v[84:87], v1, s[12:15], 0 offen offset:2688 nt
    buffer_load_dwordx4 v[92:95], v1, s[12:15], 0 offen offset:3584 nt
    buffer_load_dwordx4 v[100:103], v1, s[12:15], s29 offen offset:0 nt
    buffer_load_dwordx4 v[108:111], v1, s[12:15], s29 offen offset:896 nt
    buffer_load_dwordx4 v[116:119], v1, s[12:15], s29 offen offset:1792 nt
    buffer_load_dwordx4 v[124:127], v1, s[12:15], s29 offen offset:2688 nt
    buffer_load_dwordx4 v[132:135], v1, s[12:15], s29 offen offset:3584 nt
    buffer_load_dwordx4 v[140:143], v1, s[12:15], s30 offen offset:0 nt
    buffer_load_dwordx4 v[148:151], v1, s[12:15], s30 offen offset:896 nt
    buffer_load_dwordx4 v[156:159], v1, s[12:15], s30 offen offset:1792 nt
    buffer_load_dwordx4 v[164:167], v1, s[12:15], s30 offen offset:2688 nt
    buffer_load_dwordx4 v[172:175], v1, s[12:15], s30 offen offset:3584 nt
    buffer_load_dwordx4 v[180:183], v1, s[12:15], s31 offen offset:0 nt
    s_mov_b32 s20, s6
    s_mov_b32 s21, s7
    s_mov_b32 s24, s8
    s_mov_b32 s25, s9
    buffer_load_dwordx4 v[20:23], v3, s[20:23], 0 offen
    buffer_load_dwordx4 v[28:31], v3, s[24:27], 0 offen
    s_setprio 0
    s_add_u32 s16, s10, s3
    s_addc_u32 s17, s11, 0
    s_waitcnt vmcnt(17)
    v_lshlrev_b32 v56, 16, v60
    v_and_b32 v57, s36, v60
    v_pk_mul_f32 v[8:9], v[56:57], v[56:57]
    v_lshlrev_b32 v58, 16, v61
    v_and_b32 v59, s36, v61
    v_pk_mul_f32 v[10:11], v[58:59], v[58:59]
    v_lshlrev_b32 v60, 16, v62
    v_and_b32 v61, s36, v62
    v_pk_mul_f32 v[12:13], v[60:61], v[60:61]
    v_lshlrev_b32 v62, 16, v63
    v_and_b32 v63, s36, v63
    v_pk_mul_f32 v[14:15], v[62:63], v[62:63]
    s_waitcnt vmcnt(16)
    v_lshlrev_b32 v64, 16, v68
    v_and_b32 v65, s36, v68
    v_pk_fma_f32 v[8:9], v[64:65], v[64:65], v[8:9]
    v_lshlrev_b32 v66, 16, v69
    v_and_b32 v67, s36, v69
    v_pk_fma_f32 v[10:11], v[66:67], v[66:67], v[10:11]
    v_lshlrev_b32 v68, 16, v70
    v_and_b32 v69, s36, v70
    v_pk_fma_f32 v[12:13], v[68:69], v[68:69], v[12:13]
    v_lshlrev_b32 v70, 16, v71
    v_and_b32 v71, s36, v71
    v_pk_fma_f32 v[14:15], v[70:71], v[70:71], v[14:15]
    s_waitcnt vmcnt(15)
    v_lshlrev_b32 v72, 16, v76
    v_and_b32 v73, s36, v76
    v_pk_fma_f32 v[8:9], v[72:73], v[72:73], v[8:9]
    v_lshlrev_b32 v74, 16, v77
    v_and_b32 v75, s36, v77
    v_pk_fma_f32 v[10:11], v[74:75], v[74:75], v[10:11]
    v_lshlrev_b32 v76, 16, v78
    v_and_b32 v77, s36, v78
    v_pk_fma_f32 v[12:13], v[76:77], v[76:77], v[12:13]
    v_lshlrev_b32 v78, 16, v79
    v_and_b32 v79, s36, v79
    v_pk_fma_f32 v[14:15], v[78:79], v[78:79], v[14:15]
    s_waitcnt vmcnt(14)
    v_lshlrev_b32 v80, 16, v84
    v_and_b32 v81, s36, v84
    v_pk_fma_f32 v[8:9], v[80:81], v[80:81], v[8:9]
    v_lshlrev_b32 v82, 16, v85
    v_and_b32 v83, s36, v85
    v_pk_fma_f32 v[10:11], v[82:83], v[82:83], v[10:11]
    v_lshlrev_b32 v84, 16, v86
    v_and_b32 v85, s36, v86
    v_pk_fma_f32 v[12:13], v[84:85], v[84:85], v[12:13]
    v_lshlrev_b32 v86, 16, v87
    v_and_b32 v87, s36, v87
    v_pk_fma_f32 v[14:15], v[86:87], v[86:87], v[14:15]
    s_waitcnt vmcnt(13)
    v_lshlrev_b32 v88, 16, v92
    v_and_b32 v89, s36, v92
    v_pk_fma_f32 v[8:9], v[88:89], v[88:89], v[8:9]
    v_lshlrev_b32 v90, 16, v93
    v_and_b32 v91, s36, v93
    v_pk_fma_f32 v[10:11], v[90:91], v[90:91], v[10:11]
    v_lshlrev_b32 v92, 16, v94
    v_and_b32 v93, s36, v94
    v_pk_fma_f32 v[12:13], v[92:93], v[92:93], v[12:13]
    v_lshlrev_b32 v94, 16, v95
    v_and_b32 v95, s36, v95
    v_pk_fma_f32 v[14:15], v[94:95], v[94:95], v[14:15]
    s_waitcnt vmcnt(12)
    v_lshlrev_b32 v96, 16, v100
    v_and_b32 v97, s36, v100
    v_pk_fma_f32 v[8:9], v[96:97], v[96:97], v[8:9]
    v_lshlrev_b32 v98, 16, v101
    v_and_b32 v99, s36, v101
    v_pk_fma_f32 v[10:11], v[98:99], v[98:99], v[10:11]
    v_lshlrev_b32 v100, 16, v102
    v_and_b32 v101, s36, v102
    v_pk_fma_f32 v[12:13], v[100:101], v[100:101], v[12:13]
    v_lshlrev_b32 v102, 16, v103
    v_and_b32 v103, s36, v103
    v_pk_fma_f32 v[14:15], v[102:103], v[102:103], v[14:15]
    s_waitcnt vmcnt(11)
    v_lshlrev_b32 v104, 16, v108
    v_and_b32 v105, s36, v108
    v_pk_fma_f32 v[8:9], v[104:105], v[104:105], v[8:9]
    v_lshlrev_b32 v106, 16, v109
    v_and_b32 v107, s36, v109
    v_pk_fma_f32 v[10:11], v[106:107], v[106:107], v[10:11]
    v_lshlrev_b32 v108, 16, v110
    v_and_b32 v109, s36, v110
    v_pk_fma_f32 v[12:13], v[108:109], v[108:109], v[12:13]
    v_lshlrev_b32 v110, 16, v111
    v_and_b32 v111, s36, v111
    v_pk_fma_f32 v[14:15], v[110:111], v[110:111], v[14:15]
    s_waitcnt vmcnt(10)
    v_lshlrev_b32 v112, 16, v116
    v_and_b32 v113, s36, v116
    v_pk_fma_f32 v[8:9], v[112:113], v[112:113], v[8:9]
    v_lshlrev_b32 v114, 16, v117
    v_and_b32 v115, s36, v117
    v_pk_fma_f32 v[10:11], v[114:115], v[114:115], v[10:11]
    v_lshlrev_b32 v116, 16, v118
    v_and_b32 v117, s36, v118
    v_pk_fma_f32 v[12:13], v[116:117], v[116:117], v[12:13]
    v_lshlrev_b32 v118, 16, v119
    v_and_b32 v119, s36, v119
    v_pk_fma_f32 v[14:15], v[118:119], v[118:119], v[14:15]
    s_waitcnt vmcnt(9)
    v_lshlrev_b32 v120, 16, v124
    v_and_b32 v121, s36, v124
    v_pk_fma_f32 v[8:9], v[120:121], v[120:121], v[8:9]
    v_lshlrev_b32 v122, 16, v125
    v_and_b32 v123, s36, v125
    v_pk_fma_f32 v[10:11], v[122:123], v[122:123], v[10:11]
    v_lshlrev_b32 v124, 16, v126
    v_and_b32 v125, s36, v126
    v_pk_fma_f32 v[12:13], v[124:125], v[124:125], v[12:13]
    v_lshlrev_b32 v126, 16, v127
    v_and_b32 v127, s36, v127
    v_pk_fma_f32 v[14:15], v[126:127], v[126:127], v[14:15]
    s_waitcnt vmcnt(8)
    v_lshlrev_b32 v128, 16, v132
    v_and_b32 v129, s36, v132
    v_pk_fma_f32 v[8:9], v[128:129], v[128:129], v[8:9]
    v_lshlrev_b32 v130, 16, v133
    v_and_b32 v131, s36, v133
    v_pk_fma_f32 v[10:11], v[130:131], v[130:131], v[10:11]
    v_lshlrev_b32 v132, 16, v134
    v_and_b32 v133, s36, v134
    v_pk_fma_f32 v[12:13], v[132:133], v[132:133], v[12:13]
    v_lshlrev_b32 v134, 16, v135
    v_and_b32 v135, s36, v135
    v_pk_fma_f32 v[14:15], v[134:135], v[134:135], v[14:15]
    s_waitcnt vmcnt(7)
    v_lshlrev_b32 v136, 16, v140
    v_and_b32 v137, s36, v140
    v_pk_fma_f32 v[8:9], v[136:137], v[136:137], v[8:9]
    v_lshlrev_b32 v138, 16, v141
    v_and_b32 v139, s36, v141
    v_pk_fma_f32 v[10:11], v[138:139], v[138:139], v[10:11]
    v_lshlrev_b32 v140, 16, v142
    v_and_b32 v141, s36, v142
    v_pk_fma_f32 v[12:13], v[140:141], v[140:141], v[12:13]
    v_lshlrev_b32 v142, 16, v143
    v_and_b32 v143, s36, v143
    v_pk_fma_f32 v[14:15], v[142:143], v[142:143], v[14:15]
    s_waitcnt vmcnt(6)
    v_lshlrev_b32 v144, 16, v148
    v_and_b32 v145, s36, v148
    v_pk_fma_f32 v[8:9], v[144:145], v[144:145], v[8:9]
    v_lshlrev_b32 v146, 16, v149
    v_and_b32 v147, s36, v149
    v_pk_fma_f32 v[10:11], v[146:147], v[146:147], v[10:11]
    v_lshlrev_b32 v148, 16, v150
    v_and_b32 v149, s36, v150
    v_pk_fma_f32 v[12:13], v[148:149], v[148:149], v[12:13]
    v_lshlrev_b32 v150, 16, v151
    v_and_b32 v151, s36, v151
    v_pk_fma_f32 v[14:15], v[150:151], v[150:151], v[14:15]
    s_waitcnt vmcnt(5)
    v_lshlrev_b32 v152, 16, v156
    v_and_b32 v153, s36, v156
    v_pk_fma_f32 v[8:9], v[152:153], v[152:153], v[8:9]
    v_lshlrev_b32 v154, 16, v157
    v_and_b32 v155, s36, v157
    v_pk_fma_f32 v[10:11], v[154:155], v[154:155], v[10:11]
    v_lshlrev_b32 v156, 16, v158
    v_and_b32 v157, s36, v158
    v_pk_fma_f32 v[12:13], v[156:157], v[156:157], v[12:13]
    v_lshlrev_b32 v158, 16, v159
    v_and_b32 v159, s36, v159
    v_pk_fma_f32 v[14:15], v[158:159], v[158:159], v[14:15]
    s_waitcnt vmcnt(4)
    v_lshlrev_b32 v160, 16, v164
    v_and_b32 v161, s36, v164
    v_pk_fma_f32 v[8:9], v[160:161], v[160:161], v[8:9]
    v_lshlrev_b32 v162, 16, v165
    v_and_b32 v163, s36, v165
    v_pk_fma_f32 v[10:11], v[162:163], v[162:163], v[10:11]
    v_lshlrev_b32 v164, 16, v166
    v_and_b32 v165, s36, v166
    v_pk_fma_f32 v[12:13], v[164:165], v[164:165], v[12:13]
    v_lshlrev_b32 v166, 16, v167
    v_and_b32 v167, s36, v167
    v_pk_fma_f32 v[14:15], v[166:167], v[166:167], v[14:15]
    s_waitcnt vmcnt(3)
    v_lshlrev_b32 v168, 16, v172
    v_and_b32 v169, s36, v172
    v_pk_fma_f32 v[8:9], v[168:169], v[168:169], v[8:9]
    v_lshlrev_b32 v170, 16, v173
    v_and_b32 v171, s36, v173
    v_pk_fma_f32 v[10:11], v[170:171], v[170:171], v[10:11]
    v_lshlrev_b32 v172, 16, v174
    v_and_b32 v173, s36, v174
    v_pk_fma_f32 v[12:13], v[172:173], v[172:173], v[12:13]
    v_lshlrev_b32 v174, 16, v175
    v_and_b32 v175, s36, v175
    v_pk_fma_f32 v[14:15], v[174:175], v[174:175], v[14:15]
    s_waitcnt vmcnt(2)
    v_lshlrev_b32 v176, 16, v180
    v_and_b32 v177, s36, v180
    v_pk_fma_f32 v[8:9], v[176:177], v[176:177], v[8:9]
    v_lshlrev_b32 v178, 16, v181
    v_and_b32 v179, s36, v181
    v_pk_fma_f32 v[10:11], v[178:179], v[178:179], v[10:11]
    v_lshlrev_b32 v180, 16, v182
    v_and_b32 v181, s36, v182
    v_pk_fma_f32 v[12:13], v[180:181], v[180:181], v[12:13]
    v_lshlrev_b32 v182, 16, v183
    v_and_b32 v183, s36, v183
    v_pk_fma_f32 v[14:15], v[182:183], v[182:183], v[14:15]
    ds_write_b128 v2, v[8:11]
    ds_write_b128 v2, v[12:15] offset:896
    s_waitcnt vmcnt(0) lgkmcnt(0)
    s_barrier
    ds_read_b128 v[40:43], v4
    ds_read_b128 v[44:47], v4 offset:896
    v_lshlrev_b32 v16, 16, v20
    v_and_b32 v17, s36, v20
    v_lshlrev_b32 v18, 16, v21
    v_and_b32 v19, s36, v21
    v_lshlrev_b32 v20, 16, v22
    v_and_b32 v21, s36, v22
    v_lshlrev_b32 v22, 16, v23
    v_and_b32 v23, s36, v23
    v_lshlrev_b32 v24, 16, v28
    v_and_b32 v25, s36, v28
    v_lshlrev_b32 v26, 16, v29
    v_and_b32 v27, s36, v29
    v_lshlrev_b32 v28, 16, v30
    v_and_b32 v29, s36, v30
    v_lshlrev_b32 v30, 16, v31
    v_and_b32 v31, s36, v31
    s_waitcnt lgkmcnt(0)
    v_pk_add_f32 v[8:9], v[8:9], v[40:41]
    v_pk_add_f32 v[10:11], v[10:11], v[42:43]
    v_pk_add_f32 v[12:13], v[12:13], v[44:45]
    v_pk_add_f32 v[14:15], v[14:15], v[46:47]
    v_sqrt_f32 v8, v8
    v_sqrt_f32 v9, v9
    v_sqrt_f32 v10, v10
    v_sqrt_f32 v11, v11
    v_sqrt_f32 v12, v12
    v_sqrt_f32 v13, v13
    v_sqrt_f32 v14, v14
    v_sqrt_f32 v15, v15
    s_nop 0
    v_pk_add_f32 v[48:49], v[8:9], v[10:11]
    v_pk_add_f32 v[50:51], v[12:13], v[14:15]
    v_pk_add_f32 v[48:49], v[48:49], v[50:51]
    v_add_f32 v5, v48, v49
    v_mul_f32 v16, v16, v8
    v_mul_f32 v17, v17, v9
    v_add_f32_dpp v5, v5, v5 quad_perm:[1,0,3,2] row_mask:0xf bank_mask:0xf
    v_mul_f32 v18, v18, v10
    v_mul_f32 v19, v19, v11
    v_add_f32_dpp v5, v5, v5 quad_perm:[2,3,0,1] row_mask:0xf bank_mask:0xf
    v_mul_f32 v20, v20, v12
    v_mul_f32 v21, v21, v13
    v_add_f32_dpp v5, v5, v5 row_half_mirror row_mask:0xf bank_mask:0xf
    v_mul_f32 v22, v22, v14
    v_mul_f32 v23, v23, v15
    v_add_f32_dpp v5, v5, v5 row_mirror row_mask:0xf bank_mask:0xf
    s_nop 1
    v_add_f32_dpp v5, v5, v5 row_bcast:15 row_mask:0xa bank_mask:0xf
    s_nop 1
    v_add_f32_dpp v5, v5, v5 row_bcast:31 row_mask:0xc bank_mask:0xf
    v_mov_b32 v49, 0x358637bd
    v_readlane_b32 s37, v5, 55
    v_mov_b32 v50, 0x3b124925
    s_nop 0
    v_fma_f32 v48, s37, v50, v49
    v_rcp_f32 v6, v48
    s_nop 0
    v_fma_f32 v32, v16, v6, 1.0
    v_fma_f32 v33, v17, v6, 1.0
    v_fma_f32 v34, v18, v6, 1.0
    v_fma_f32 v35, v19, v6, 1.0
    v_fma_f32 v36, v20, v6, 1.0
    v_fma_f32 v37, v21, v6, 1.0
    v_fma_f32 v38, v22, v6, 1.0
    v_fma_f32 v39, v23, v6, 1.0
    v_pk_fma_f32 v[56:57], v[56:57], v[32:33], v[24:25]
    v_pk_fma_f32 v[58:59], v[58:59], v[34:35], v[26:27]
    v_pk_fma_f32 v[60:61], v[60:61], v[36:37], v[28:29]
    v_pk_fma_f32 v[62:63], v[62:63], v[38:39], v[30:31]
    v_cvt_pk_bf16_f32 v56, v56, v57
    v_cvt_pk_bf16_f32 v57, v58, v59
    v_cvt_pk_bf16_f32 v58, v60, v61
    v_cvt_pk_bf16_f32 v59, v62, v63
    buffer_store_dwordx4 v[56:59], v1, s[16:19], 0 offen offset:0 nt
    v_pk_fma_f32 v[64:65], v[64:65], v[32:33], v[24:25]
    v_pk_fma_f32 v[66:67], v[66:67], v[34:35], v[26:27]
    v_pk_fma_f32 v[68:69], v[68:69], v[36:37], v[28:29]
    v_pk_fma_f32 v[70:71], v[70:71], v[38:39], v[30:31]
    v_cvt_pk_bf16_f32 v64, v64, v65
    v_cvt_pk_bf16_f32 v65, v66, v67
    v_cvt_pk_bf16_f32 v66, v68, v69
    v_cvt_pk_bf16_f32 v67, v70, v71
    buffer_store_dwordx4 v[64:67], v1, s[16:19], 0 offen offset:896 nt
    v_pk_fma_f32 v[72:73], v[72:73], v[32:33], v[24:25]
    v_pk_fma_f32 v[74:75], v[74:75], v[34:35], v[26:27]
    v_pk_fma_f32 v[76:77], v[76:77], v[36:37], v[28:29]
    v_pk_fma_f32 v[78:79], v[78:79], v[38:39], v[30:31]
    v_cvt_pk_bf16_f32 v72, v72, v73
    v_cvt_pk_bf16_f32 v73, v74, v75
    v_cvt_pk_bf16_f32 v74, v76, v77
    v_cvt_pk_bf16_f32 v75, v78, v79
    buffer_store_dwordx4 v[72:75], v1, s[16:19], 0 offen offset:1792 nt
    v_pk_fma_f32 v[80:81], v[80:81], v[32:33], v[24:25]
    v_pk_fma_f32 v[82:83], v[82:83], v[34:35], v[26:27]
    v_pk_fma_f32 v[84:85], v[84:85], v[36:37], v[28:29]
    v_pk_fma_f32 v[86:87], v[86:87], v[38:39], v[30:31]
    v_cvt_pk_bf16_f32 v80, v80, v81
    v_cvt_pk_bf16_f32 v81, v82, v83
    v_cvt_pk_bf16_f32 v82, v84, v85
    v_cvt_pk_bf16_f32 v83, v86, v87
    buffer_store_dwordx4 v[80:83], v1, s[16:19], 0 offen offset:2688 nt
    v_pk_fma_f32 v[88:89], v[88:89], v[32:33], v[24:25]
    v_pk_fma_f32 v[90:91], v[90:91], v[34:35], v[26:27]
    v_pk_fma_f32 v[92:93], v[92:93], v[36:37], v[28:29]
    v_pk_fma_f32 v[94:95], v[94:95], v[38:39], v[30:31]
    v_cvt_pk_bf16_f32 v88, v88, v89
    v_cvt_pk_bf16_f32 v89, v90, v91
    v_cvt_pk_bf16_f32 v90, v92, v93
    v_cvt_pk_bf16_f32 v91, v94, v95
    buffer_store_dwordx4 v[88:91], v1, s[16:19], 0 offen offset:3584 nt
    v_pk_fma_f32 v[96:97], v[96:97], v[32:33], v[24:25]
    v_pk_fma_f32 v[98:99], v[98:99], v[34:35], v[26:27]
    v_pk_fma_f32 v[100:101], v[100:101], v[36:37], v[28:29]
    v_pk_fma_f32 v[102:103], v[102:103], v[38:39], v[30:31]
    v_cvt_pk_bf16_f32 v96, v96, v97
    v_cvt_pk_bf16_f32 v97, v98, v99
    v_cvt_pk_bf16_f32 v98, v100, v101
    v_cvt_pk_bf16_f32 v99, v102, v103
    buffer_store_dwordx4 v[96:99], v1, s[16:19], s29 offen offset:0 nt
    v_pk_fma_f32 v[104:105], v[104:105], v[32:33], v[24:25]
    v_pk_fma_f32 v[106:107], v[106:107], v[34:35], v[26:27]
    v_pk_fma_f32 v[108:109], v[108:109], v[36:37], v[28:29]
    v_pk_fma_f32 v[110:111], v[110:111], v[38:39], v[30:31]
    v_cvt_pk_bf16_f32 v104, v104, v105
    v_cvt_pk_bf16_f32 v105, v106, v107
    v_cvt_pk_bf16_f32 v106, v108, v109
    v_cvt_pk_bf16_f32 v107, v110, v111
    buffer_store_dwordx4 v[104:107], v1, s[16:19], s29 offen offset:896 nt
    v_pk_fma_f32 v[112:113], v[112:113], v[32:33], v[24:25]
    v_pk_fma_f32 v[114:115], v[114:115], v[34:35], v[26:27]
    v_pk_fma_f32 v[116:117], v[116:117], v[36:37], v[28:29]
    v_pk_fma_f32 v[118:119], v[118:119], v[38:39], v[30:31]
    v_cvt_pk_bf16_f32 v112, v112, v113
    v_cvt_pk_bf16_f32 v113, v114, v115
    v_cvt_pk_bf16_f32 v114, v116, v117
    v_cvt_pk_bf16_f32 v115, v118, v119
    buffer_store_dwordx4 v[112:115], v1, s[16:19], s29 offen offset:1792 nt
    v_pk_fma_f32 v[120:121], v[120:121], v[32:33], v[24:25]
    v_pk_fma_f32 v[122:123], v[122:123], v[34:35], v[26:27]
    v_pk_fma_f32 v[124:125], v[124:125], v[36:37], v[28:29]
    v_pk_fma_f32 v[126:127], v[126:127], v[38:39], v[30:31]
    v_cvt_pk_bf16_f32 v120, v120, v121
    v_cvt_pk_bf16_f32 v121, v122, v123
    v_cvt_pk_bf16_f32 v122, v124, v125
    v_cvt_pk_bf16_f32 v123, v126, v127
    buffer_store_dwordx4 v[120:123], v1, s[16:19], s29 offen offset:2688 nt
    v_pk_fma_f32 v[128:129], v[128:129], v[32:33], v[24:25]
    v_pk_fma_f32 v[130:131], v[130:131], v[34:35], v[26:27]
    v_pk_fma_f32 v[132:133], v[132:133], v[36:37], v[28:29]
    v_pk_fma_f32 v[134:135], v[134:135], v[38:39], v[30:31]
    v_cvt_pk_bf16_f32 v128, v128, v129
    v_cvt_pk_bf16_f32 v129, v130, v131
    v_cvt_pk_bf16_f32 v130, v132, v133
    v_cvt_pk_bf16_f32 v131, v134, v135
    buffer_store_dwordx4 v[128:131], v1, s[16:19], s29 offen offset:3584 nt
    v_pk_fma_f32 v[136:137], v[136:137], v[32:33], v[24:25]
    v_pk_fma_f32 v[138:139], v[138:139], v[34:35], v[26:27]
    v_pk_fma_f32 v[140:141], v[140:141], v[36:37], v[28:29]
    v_pk_fma_f32 v[142:143], v[142:143], v[38:39], v[30:31]
    v_cvt_pk_bf16_f32 v136, v136, v137
    v_cvt_pk_bf16_f32 v137, v138, v139
    v_cvt_pk_bf16_f32 v138, v140, v141
    v_cvt_pk_bf16_f32 v139, v142, v143
    buffer_store_dwordx4 v[136:139], v1, s[16:19], s30 offen offset:0 nt
    v_pk_fma_f32 v[144:145], v[144:145], v[32:33], v[24:25]
    v_pk_fma_f32 v[146:147], v[146:147], v[34:35], v[26:27]
    v_pk_fma_f32 v[148:149], v[148:149], v[36:37], v[28:29]
    v_pk_fma_f32 v[150:151], v[150:151], v[38:39], v[30:31]
    v_cvt_pk_bf16_f32 v144, v144, v145
    v_cvt_pk_bf16_f32 v145, v146, v147
    v_cvt_pk_bf16_f32 v146, v148, v149
    v_cvt_pk_bf16_f32 v147, v150, v151
    buffer_store_dwordx4 v[144:147], v1, s[16:19], s30 offen offset:896 nt
    v_pk_fma_f32 v[152:153], v[152:153], v[32:33], v[24:25]
    v_pk_fma_f32 v[154:155], v[154:155], v[34:35], v[26:27]
    v_pk_fma_f32 v[156:157], v[156:157], v[36:37], v[28:29]
    v_pk_fma_f32 v[158:159], v[158:159], v[38:39], v[30:31]
    v_cvt_pk_bf16_f32 v152, v152, v153
    v_cvt_pk_bf16_f32 v153, v154, v155
    v_cvt_pk_bf16_f32 v154, v156, v157
    v_cvt_pk_bf16_f32 v155, v158, v159
    buffer_store_dwordx4 v[152:155], v1, s[16:19], s30 offen offset:1792 nt
    v_pk_fma_f32 v[160:161], v[160:161], v[32:33], v[24:25]
    v_pk_fma_f32 v[162:163], v[162:163], v[34:35], v[26:27]
    v_pk_fma_f32 v[164:165], v[164:165], v[36:37], v[28:29]
    v_pk_fma_f32 v[166:167], v[166:167], v[38:39], v[30:31]
    v_cvt_pk_bf16_f32 v160, v160, v161
    v_cvt_pk_bf16_f32 v161, v162, v163
    v_cvt_pk_bf16_f32 v162, v164, v165
    v_cvt_pk_bf16_f32 v163, v166, v167
    buffer_store_dwordx4 v[160:163], v1, s[16:19], s30 offen offset:2688 nt
    v_pk_fma_f32 v[168:169], v[168:169], v[32:33], v[24:25]
    v_pk_fma_f32 v[170:171], v[170:171], v[34:35], v[26:27]
    v_pk_fma_f32 v[172:173], v[172:173], v[36:37], v[28:29]
    v_pk_fma_f32 v[174:175], v[174:175], v[38:39], v[30:31]
    v_cvt_pk_bf16_f32 v168, v168, v169
    v_cvt_pk_bf16_f32 v169, v170, v171
    v_cvt_pk_bf16_f32 v170, v172, v173
    v_cvt_pk_bf16_f32 v171, v174, v175
    buffer_store_dwordx4 v[168:171], v1, s[16:19], s30 offen offset:3584 nt
    v_pk_fma_f32 v[176:177], v[176:177], v[32:33], v[24:25]
    v_pk_fma_f32 v[178:179], v[178:179], v[34:35], v[26:27]
    v_pk_fma_f32 v[180:181], v[180:181], v[36:37], v[28:29]
    v_pk_fma_f32 v[182:183], v[182:183], v[38:39], v[30:31]
    v_cvt_pk_bf16_f32 v176, v176, v177
    v_cvt_pk_bf16_f32 v177, v178, v179
    v_cvt_pk_bf16_f32 v178, v180, v181
    v_cvt_pk_bf16_f32 v179, v182, v183
    buffer_store_dwordx4 v[176:179], v1, s[16:19], s31 offen offset:0 nt
L_done:
s_endpgm
.section .rodata,"a"
.p2align 6
.amdhsa_kernel standalone__grn__sampling_kernel
  .amdhsa_next_free_vgpr 184
  .amdhsa_next_free_sgpr 48
  .amdhsa_accum_offset 184
  .amdhsa_group_segment_fixed_size 0
  .amdhsa_kernarg_size 48
  .amdhsa_float_denorm_mode_32 3
  .amdhsa_user_sgpr_count 2
  .amdhsa_user_sgpr_kernarg_segment_ptr 1
  .amdhsa_system_sgpr_workgroup_id_x 1
.end_amdhsa_kernel
```
